```python
import torch

def _softmax(x, axis=-1):
    return torch.softmax(x, dim=axis)
def _gelu(x):
    return torch.nn.functional.gelu(x, approximate="tanh")
def _silu(x):
    return torch.nn.functional.silu(x)
def _sigmoid(x):
    return torch.sigmoid(x)
def _layernorm(x, axis=-1, eps=1e-5):
    m = x.mean(dim=axis, keepdim=True)
    v = x.var(dim=axis, keepdim=True, unbiased=False)
    return (x - m) / torch.sqrt(v + eps)
def _scatter_add(tgt, idx, src, axis=0):
    return tgt.clone().index_add_(axis, idx, src)
def _segment_sum(src, seg, n):
    out = torch.zeros((n,) + src.shape[1:], dtype=src.dtype)
    return out.index_add_(0, seg, src)
def _pad(x, pw):
    flat = tuple(v for pair in reversed(pw) for v in pair)
    return torch.nn.functional.pad(x, flat)

kernel_name = 'recurrent_scan__sliding_block_cached__mixer_token_mlp__decode'

def setup_inputs():

    _w = (lambda a: (lambda t: t.to(torch.bfloat16) if t.is_floating_point() else t)(torch.as_tensor(a)))
    def _A_setup():
        B, Sq, D = 2, 1, 512
        Hq, Hkv, Sk, Dh = 32, 32, 4096, 128
        assert Hq % Hkv == 0, (Hq, Hkv)
        return {
            "x": _w((lambda *s: torch.randn(*s, dtype=torch.bfloat16) * 0.4)(B, Sq, D)),
            "k_cache": _w((lambda *s: torch.randn(*s, dtype=torch.bfloat16) * 1.6)(B, Hkv, Sk, Dh)),
            "v_cache": _w((lambda *s: torch.randn(*s, dtype=torch.bfloat16) * 1.6)(B, Hkv, Sk, Dh)),
            "wq": _w((lambda *s: torch.randn(*s, dtype=torch.bfloat16) * 1.6)(D, Hq * Dh) * (D ** -0.5)),
            "wo": _w((lambda *s: torch.randn(*s, dtype=torch.bfloat16) * 1.6)(Hq * Dh, D) * ((Hq * Dh) ** -0.5)),
        }
    _A_in = _A_setup()

    def _B_setup():
        B, S, D, F = 2, 1, 512, 1376
        return {
            "x": _w((lambda *s: torch.randn(*s, dtype=torch.bfloat16) * 0.4)(B, S, D)),
            "w1": _w((lambda *s: torch.randn(*s, dtype=torch.bfloat16) * 1.6)(S, F) * (S ** -0.5)),
            "b1": _w((lambda *s: torch.randn(*s, dtype=torch.bfloat16) * 1.6)(F) * 0.02),
            "w2": _w((lambda *s: torch.randn(*s, dtype=torch.bfloat16) * 1.6)(F, S) * (F ** -0.5)),
            "b2": _w((lambda *s: torch.randn(*s, dtype=torch.bfloat16) * 1.6)(S) * 0.02),
        }
    _B_in = _B_setup()

    return {
        "A_x": _A_in["x"],
        "A_k_cache": _A_in["k_cache"],
        "A_v_cache": _A_in["v_cache"],
        "A_wq": _A_in["wq"],
        "A_wo": _A_in["wo"],
        "B_x": _B_in["x"],
        "B_w1": _B_in["w1"],
        "B_b1": _B_in["b1"],
        "B_w2": _B_in["w2"],
        "B_b2": _B_in["b2"],
    }

def reference(A_x, A_k_cache, A_v_cache, A_wq, A_wo, B_x, B_w1, B_b1, B_w2, B_b2):
    def _A_ref(x, k_cache, v_cache, wq, wo):
        B, Sq, D = x.shape
        Hq, Dh = 32, 128
        Hkv, Sk = k_cache.shape[1], k_cache.shape[2]
        W = min(4096, max(256, Sk // 4))
        rep = Hq // Hkv
        q = (lambda x, *d: x.permute(*d))((x @ wq).reshape(B, Sq, Hq, Dh), 0, 2, 1, 3)
        k = (lambda x, n, axis: torch.repeat_interleave(x, n, dim=axis))(k_cache[:, :, Sk - W:, :], rep, axis=1)
        v = (lambda x, n, axis: torch.repeat_interleave(x, n, dim=axis))(v_cache[:, :, Sk - W:, :], rep, axis=1)
        scores = torch.einsum("bhqd,bhkd->bhqk", q, k) * (Dh ** -0.5)
        p = _softmax(scores, axis=-1)
        o = torch.einsum("bhqk,bhkd->bhqd", p, v)
        return (lambda x, *d: x.permute(*d))(o, 0, 2, 1, 3).reshape(B, Sq, Hq * Dh) @ wo

    def _B_ref(x, w1, b1, w2, b2):
        B, S, D = x.shape
        h = _layernorm(x, axis=-1)
        u = torch.einsum("bsd,sf->bdf", h, w1) + b1
        u = _gelu(u)
        y = torch.einsum("bdf,fs->bds", u, w2) + b2
        return (lambda x, *d: x.permute(*d))(y, 0, 2, 1)

    x = A_x
    xn = _layernorm(x, axis=-1)
    s = _A_ref(xn, A_k_cache, A_v_cache, A_wq, A_wo)
    g = _silu(_B_ref(xn, B_w1, B_b1, B_w2, B_b2))
    return x + s * g
```

```asm
; @launch grid=(256,1,1) block=(768,1,1) lds=24576
.amdgcn_target "amdgcn-amd-amdhsa--gfx950"
.text
.globl recurrent_scan__sliding_block_cached__mixer_token_mlp__decode_kernel
.p2align 8
.type recurrent_scan__sliding_block_cached__mixer_token_mlp__decode_kernel,@function
recurrent_scan__sliding_block_cached__mixer_token_mlp__decode_kernel:
    s_load_dwordx16 s[4:19], s[0:1], 0
    v_readfirstlane_b32 s3, v0
    s_lshr_b32 s36, s2, 8
    s_cbranch_scc1 L_end
    s_cmp_eq_u32 s3, 0
    s_cbranch_scc1 L_q
    s_lshr_b32 s42, s2, 5
    s_and_b32 s30, s2, 31
    s_add_u32 s41, s3, s30
    s_lshl_b32 s41, s41, 8
    s_lshl3_add_u32 s40, s42, -1
    s_lshl_b32 s40, s40, 16
    s_add_u32 s40, s40, s41
    v_and_b32 v3, 48, v0
    v_lshlrev_b32 v5, 13, v3
    v_and_b32 v4, 15, v0
    v_lshl_or_b32 v5, v4, 4, v5
    v_add_u32 v5, s40, v5
    s_lshl_b32 m0, s3, 5
    s_lshr_b32 s36, s3, 8
    s_cbranch_scc0 L_qm
    v_add_u32 v6, 0x1c00, v5
    s_and_b32 s33, s2, 63
    s_lshr_b32 s31, s2, 6
    s_lshl4_add_u32 s34, s33, s31
    s_lshl_b32 s34, s34, 9
    s_add_u32 s34, s34, s3
    s_addk_i32 s34, 5920
    v_and_b32 v7, 3, v0
    v_lshlrev_b32 v1, 4, v7
    v_and_b32 v7, 12, v0
    v_lshl_or_b32 v1, v7, 6, v1
    v_lshl_or_b32 v1, v3, 2, v1
    v_lshl_add_u32 v1, s34, 7, v1
    s_cmpk_gt_u32 s3, 512
    s_waitcnt lgkmcnt(0)
    s_cbranch_scc1 L_nowq
    global_load_lds_dwordx4 v5, s[10:11] offset:0 nt
    global_load_lds_dwordx4 v6, s[10:11] offset:1024 nt
L_nowq:
    global_load_dwordx4 v[8:11], v1, s[6:7] offset:-4096 nt
    s_branch L_s2
L_qm:
    s_getpc_b64 s[38:39]
L_pc:
    v_mul_u32_u24 v7, 46, v0
    global_load_ubyte v72, v7, s[38:39] offset:-3148
    v_add_u32 v6, 0x21c00, v5
    s_addk_i32 m0, 0x4000
    v_add_u32 v5, 0x20000, v5
    s_waitcnt lgkmcnt(0)
    global_load_lds_dwordx4 v5, s[10:11] offset:0 nt
    global_load_lds_dwordx4 v6, s[10:11] offset:1024 nt
    s_branch L_mix
L_q:
    v_lshlrev_b32 v137, 4, v0
    s_movk_i32 m0, 6144
    s_waitcnt lgkmcnt(0)
    global_load_lds_dwordx4 v137, s[4:5]
    global_load_lds_dwordx4 v137, s[4:5] offset:1024
L_q0:
L_q1:
    v_mov_b32 v136, 0
    v_lshlrev_b32 v40, 2, v0
    ds_write_b32 v40, v136 offset:256
    s_load_dwordx8 s[20:27], s[0:1], 64
    s_load_dwordx2 s[28:29], s[0:1], 96
    s_setprio 3
    v_and_b32 v40, 8, v0
    v_lshlrev_b32 v40, 7, v40
    v_and_b32 v41, 48, v0
    v_and_b32 v42, 7, v0
    v_lshl_or_b32 v5, v41, 4, v40
    v_lshl_or_b32 v5, v42, 5, v5
    s_lshr_b32 s42, s2, 5
    s_lshl_b32 s36, s42, 7
    v_lshl_or_b32 v134, v41, 1, v40
    v_add_u32 v134, s36, v134
    s_waitcnt lgkmcnt(0)
    s_load_dword s37, s[28:29], 0
    s_and_b32 s30, s2, 31
    s_lshr_b32 s31, s2, 6
    s_bfe_u32 s32, s2, 0x10005
    s_lshr_b32 s33, s30, 4
    s_and_b32 s35, s2, 15
    s_lshr_b32 s36, s2, 5
    s_lshl3_add_u32 s35, s35, s36
    s_lshl_b32 s36, s33, 10
    s_lshl3_add_u32 s36, s35, s36
    v_lshrrev_b32 v3, 3, v41
    v_add_u32 v3, s36, v3
    v_mov_b32 v1, 0
    v_mov_b32 v2, 0
    global_load_short_d16_hi v1, v3, s[4:5]
    global_load_short_d16_hi v2, v136, s[22:23]
    s_mov_b32 s58, 0xffff0000
    v_and_b32 v126, 1, v0
    v_cmp_eq_u32 vcc, 1, v126
    v_mov_b32 v124, 0x0c0c0100
    v_mov_b32 v125, 0x01000c0c
    v_cndmask_b32 v126, v124, v125, vcc
    v_mov_b32 v124, 0x0c0c0302
    v_mov_b32 v125, 0x03020c0c
    v_cndmask_b32 v127, v124, v125, vcc
    v_mov_b32 v124, 0x0c0c0c0c
    s_mov_b32 s60, 0x03030303
    s_mov_b32 s61, s60
    v_cndmask_b32 v112, v124, v126, s[60:61]
    v_cndmask_b32 v116, v124, v127, s[60:61]
    s_lshl_b64 s[60:61], s[60:61], 2
    v_cndmask_b32 v113, v124, v126, s[60:61]
    v_cndmask_b32 v117, v124, v127, s[60:61]
    s_lshl_b64 s[60:61], s[60:61], 2
    v_cndmask_b32 v114, v124, v126, s[60:61]
    v_cndmask_b32 v118, v124, v127, s[60:61]
    s_lshl_b64 s[60:61], s[60:61], 2
    v_cndmask_b32 v115, v124, v126, s[60:61]
    v_cndmask_b32 v119, v124, v127, s[60:61]
    s_mov_b32 s62, 0x07060500
    s_mov_b32 s63, 0x07060501
    s_mov_b32 s64, 0x07060502
    s_mov_b32 s65, 0x07060503
    s_mov_b32 s66, 0x0c0c0400
    s_mov_b32 s67, 0x04000c0c
    s_lshl_b32 s40, s30, 13
    s_add_u32 s36, s40, 65536
    s_add_u32 s54, s28, s36
    s_addc_u32 s55, s29, 0
    s_add_u32 s60, s54, 2097152
    s_addc_u32 s61, s55, 0
    s_lshl_b32 s41, s42, 10
    v_add_u32 v6, s41, v137
    v_and_b32 v43, 31, v0
    v_lshlrev_b32 v43, 4, v43
    v_and_b32 v44, 32, v0
    v_lshl_or_b32 v43, v44, 5, v43
    s_lshl_b32 s36, s32, 9
    s_add_u32 s36, s36, 4096
    v_add_u32 v4, s36, v43
    s_waitcnt lgkmcnt(0)
    s_add_u32 s37, s37, 0x01010101
    s_xor_b32 s43, s37, 0xa9533c00
    v_mov_b32 v7, s43
    ds_write_b32 v136, v7 offset:260
    s_waitcnt vmcnt(2)
    ds_read_b128 v[8:11], v5 offset:6144
    ds_read_b128 v[12:15], v5 offset:6160
    ds_read_b128 v[16:19], v134 offset:6144
    ds_read_b128 v[20:23], v134 offset:6160
    s_waitcnt lgkmcnt(2)
    v_lshlrev_b32 v24, 16, v8
    v_and_b32 v25, s58, v8
    v_lshlrev_b32 v26, 16, v9
    v_and_b32 v27, s58, v9
    v_lshlrev_b32 v28, 16, v10
    v_and_b32 v29, s58, v10
    v_lshlrev_b32 v30, 16, v11
    v_and_b32 v31, s58, v11
    v_lshlrev_b32 v32, 16, v12
    v_and_b32 v33, s58, v12
    v_lshlrev_b32 v34, 16, v13
    v_and_b32 v35, s58, v13
    v_lshlrev_b32 v36, 16, v14
    v_and_b32 v37, s58, v14
    v_lshlrev_b32 v38, 16, v15
    v_and_b32 v39, s58, v15
    v_pk_add_f32 v[40:41], v[24:25], v[26:27]
    v_pk_add_f32 v[42:43], v[28:29], v[30:31]
    v_pk_add_f32 v[44:45], v[32:33], v[34:35]
    v_pk_add_f32 v[46:47], v[36:37], v[38:39]
    v_pk_add_f32 v[40:41], v[40:41], v[42:43]
    v_pk_add_f32 v[44:45], v[44:45], v[46:47]
    v_pk_add_f32 v[40:41], v[40:41], v[44:45]
    v_add_f32 v134, v40, v41
    s_nop 1
    v_add_f32_dpp v134, v134, v134 quad_perm:[1,0,3,2] row_mask:0xf bank_mask:0xf
    s_nop 1
    v_add_f32_dpp v134, v134, v134 quad_perm:[2,3,0,1] row_mask:0xf bank_mask:0xf
    s_nop 1
    v_add_f32_dpp v134, v134, v134 row_half_mirror row_mask:0xf bank_mask:0xf
    v_mov_b32 v40, v134
    s_nop 1
    v_permlane16_swap_b32 v134, v40
    v_add_f32 v134, v134, v40
    v_mov_b32 v40, v134
    s_nop 1
    v_permlane32_swap_b32 v134, v40
    v_add_f32 v134, v134, v40
    v_mul_f32 v128, 0x3b000000, v134
    v_pk_add_f32 v[40:41], v[24:25], v[128:129] op_sel_hi:[1,0] neg_lo:[0,1] neg_hi:[0,1]
    v_pk_mul_f32 v[44:45], v[40:41], v[40:41]
    v_pk_add_f32 v[42:43], v[26:27], v[128:129] op_sel_hi:[1,0] neg_lo:[0,1] neg_hi:[0,1]
    v_pk_fma_f32 v[44:45], v[42:43], v[42:43], v[44:45]
    v_pk_add_f32 v[40:41], v[28:29], v[128:129] op_sel_hi:[1,0] neg_lo:[0,1] neg_hi:[0,1]
    v_pk_fma_f32 v[44:45], v[40:41], v[40:41], v[44:45]
    v_pk_add_f32 v[42:43], v[30:31], v[128:129] op_sel_hi:[1,0] neg_lo:[0,1] neg_hi:[0,1]
    v_pk_fma_f32 v[44:45], v[42:43], v[42:43], v[44:45]
    v_pk_add_f32 v[40:41], v[32:33], v[128:129] op_sel_hi:[1,0] neg_lo:[0,1] neg_hi:[0,1]
    v_pk_fma_f32 v[44:45], v[40:41], v[40:41], v[44:45]
    v_pk_add_f32 v[42:43], v[34:35], v[128:129] op_sel_hi:[1,0] neg_lo:[0,1] neg_hi:[0,1]
    v_pk_fma_f32 v[44:45], v[42:43], v[42:43], v[44:45]
    v_pk_add_f32 v[40:41], v[36:37], v[128:129] op_sel_hi:[1,0] neg_lo:[0,1] neg_hi:[0,1]
    v_pk_fma_f32 v[44:45], v[40:41], v[40:41], v[44:45]
    v_pk_add_f32 v[42:43], v[38:39], v[128:129] op_sel_hi:[1,0] neg_lo:[0,1] neg_hi:[0,1]
    v_pk_fma_f32 v[44:45], v[42:43], v[42:43], v[44:45]
    v_add_f32 v134, v44, v45
    s_nop 1
    v_add_f32_dpp v134, v134, v134 quad_perm:[1,0,3,2] row_mask:0xf bank_mask:0xf
    s_nop 1
    v_add_f32_dpp v134, v134, v134 quad_perm:[2,3,0,1] row_mask:0xf bank_mask:0xf
    s_nop 1
    v_add_f32_dpp v134, v134, v134 row_half_mirror row_mask:0xf bank_mask:0xf
    v_mov_b32 v40, v134
    s_nop 1
    v_permlane16_swap_b32 v134, v40
    v_add_f32 v134, v134, v40
    v_mov_b32 v40, v134
    s_nop 1
    v_permlane32_swap_b32 v134, v40
    v_add_f32 v134, v134, v40
    v_mul_f32 v134, 0x3b000000, v134
    v_cvt_pk_bf16_f32 v40, v128, v134
    v_lshlrev_b32 v130, 16, v40
    v_and_b32 v134, s58, v40
    v_add_f32 v134, 0x3727c5ac, v134
    v_cvt_pk_bf16_f32 v40, v134, v134
    v_and_b32 v134, s58, v40
    v_sqrt_f32 v134, v134
    s_nop 0
    v_cvt_pk_bf16_f32 v40, v134, v134
    v_and_b32 v134, s58, v40
    v_rcp_f32 v132, v134
    s_nop 0
    s_waitcnt lgkmcnt(0)
    s_barrier
    ds_read_b128 v[48:51], v137 offset:8192
    ds_read_b128 v[52:55], v137 offset:9216
    ds_read_b128 v[56:59], v137 offset:10240
    ds_read_b128 v[60:63], v137 offset:11264
    ds_read_b128 v[64:67], v137 offset:12288
    ds_read_b128 v[68:71], v137 offset:13312
    ds_read_b128 v[72:75], v137 offset:14336
    ds_read_b128 v[76:79], v137 offset:15360
    ds_read_b128 v[80:83], v137 offset:16384
    ds_read_b128 v[84:87], v137 offset:17408
    ds_read_b128 v[88:91], v137 offset:18432
    ds_read_b128 v[92:95], v137 offset:19456
    ds_read_b128 v[96:99], v137 offset:20480
    ds_read_b128 v[100:103], v137 offset:21504
    ds_read_b128 v[104:107], v137 offset:22528
    ds_read_b128 v[108:111], v137 offset:23552
    v_lshlrev_b32 v24, 16, v16
    v_and_b32 v25, s58, v16
    v_lshlrev_b32 v26, 16, v17
    v_and_b32 v27, s58, v17
    v_lshlrev_b32 v28, 16, v18
    v_and_b32 v29, s58, v18
    v_lshlrev_b32 v30, 16, v19
    v_and_b32 v31, s58, v19
    v_lshlrev_b32 v32, 16, v20
    v_and_b32 v33, s58, v20
    v_lshlrev_b32 v34, 16, v21
    v_and_b32 v35, s58, v21
    v_lshlrev_b32 v36, 16, v22
    v_and_b32 v37, s58, v22
    v_lshlrev_b32 v38, 16, v23
    v_and_b32 v39, s58, v23
    v_pk_add_f32 v[40:41], v[24:25], v[130:131] op_sel_hi:[1,0] neg_lo:[0,1] neg_hi:[0,1]
    v_cvt_pk_bf16_f32 v40, v40, v41
    v_and_b32 v41, s58, v40
    v_lshlrev_b32 v40, 16, v40
    v_pk_mul_f32 v[40:41], v[40:41], v[132:133] op_sel_hi:[1,0]
    v_cvt_pk_bf16_f32 v16, v40, v41
    v_pk_add_f32 v[42:43], v[26:27], v[130:131] op_sel_hi:[1,0] neg_lo:[0,1] neg_hi:[0,1]
    v_cvt_pk_bf16_f32 v42, v42, v43
    v_and_b32 v43, s58, v42
    v_lshlrev_b32 v42, 16, v42
    v_pk_mul_f32 v[42:43], v[42:43], v[132:133] op_sel_hi:[1,0]
    v_cvt_pk_bf16_f32 v17, v42, v43
    v_pk_add_f32 v[44:45], v[28:29], v[130:131] op_sel_hi:[1,0] neg_lo:[0,1] neg_hi:[0,1]
    v_cvt_pk_bf16_f32 v44, v44, v45
    v_and_b32 v45, s58, v44
    v_lshlrev_b32 v44, 16, v44
    v_pk_mul_f32 v[44:45], v[44:45], v[132:133] op_sel_hi:[1,0]
    v_cvt_pk_bf16_f32 v18, v44, v45
    v_pk_add_f32 v[46:47], v[30:31], v[130:131] op_sel_hi:[1,0] neg_lo:[0,1] neg_hi:[0,1]
    v_cvt_pk_bf16_f32 v46, v46, v47
    v_and_b32 v47, s58, v46
    v_lshlrev_b32 v46, 16, v46
    v_pk_mul_f32 v[46:47], v[46:47], v[132:133] op_sel_hi:[1,0]
    v_cvt_pk_bf16_f32 v19, v46, v47
    v_pk_add_f32 v[40:41], v[32:33], v[130:131] op_sel_hi:[1,0] neg_lo:[0,1] neg_hi:[0,1]
    v_cvt_pk_bf16_f32 v40, v40, v41
    v_and_b32 v41, s58, v40
    v_lshlrev_b32 v40, 16, v40
    v_pk_mul_f32 v[40:41], v[40:41], v[132:133] op_sel_hi:[1,0]
    v_cvt_pk_bf16_f32 v20, v40, v41
    v_pk_add_f32 v[42:43], v[34:35], v[130:131] op_sel_hi:[1,0] neg_lo:[0,1] neg_hi:[0,1]
    v_cvt_pk_bf16_f32 v42, v42, v43
    v_and_b32 v43, s58, v42
    v_lshlrev_b32 v42, 16, v42
    v_pk_mul_f32 v[42:43], v[42:43], v[132:133] op_sel_hi:[1,0]
    v_cvt_pk_bf16_f32 v21, v42, v43
    v_pk_add_f32 v[44:45], v[36:37], v[130:131] op_sel_hi:[1,0] neg_lo:[0,1] neg_hi:[0,1]
    v_cvt_pk_bf16_f32 v44, v44, v45
    v_and_b32 v45, s58, v44
    v_lshlrev_b32 v44, 16, v44
    v_pk_mul_f32 v[44:45], v[44:45], v[132:133] op_sel_hi:[1,0]
    v_cvt_pk_bf16_f32 v22, v44, v45
    v_pk_add_f32 v[46:47], v[38:39], v[130:131] op_sel_hi:[1,0] neg_lo:[0,1] neg_hi:[0,1]
    v_cvt_pk_bf16_f32 v46, v46, v47
    v_and_b32 v47, s58, v46
    v_lshlrev_b32 v46, 16, v46
    v_pk_mul_f32 v[46:47], v[46:47], v[132:133] op_sel_hi:[1,0]
    v_cvt_pk_bf16_f32 v23, v46, v47
    v_perm_b32 v120, v16, v16, v112
    v_perm_b32 v121, v16, v16, v113
    v_perm_b32 v122, v16, v16, v114
    v_perm_b32 v123, v16, v16, v115
    v_perm_b32 v124, v16, v16, v116
    v_perm_b32 v125, v16, v16, v117
    v_perm_b32 v126, v16, v16, v118
    v_perm_b32 v127, v16, v16, v119
    s_waitcnt lgkmcnt(15)
    v_mfma_f32_16x16x32_bf16 v[24:27], v[120:123], v[48:51], 0
    v_perm_b32 v120, v17, v17, v112
    v_perm_b32 v121, v17, v17, v113
    v_perm_b32 v122, v17, v17, v114
    v_perm_b32 v123, v17, v17, v115
    s_waitcnt lgkmcnt(14)
    v_mfma_f32_16x16x32_bf16 v[24:27], v[124:127], v[52:55], v[24:27]
    v_perm_b32 v124, v17, v17, v116
    v_perm_b32 v125, v17, v17, v117
    v_perm_b32 v126, v17, v17, v118
    v_perm_b32 v127, v17, v17, v119
    s_waitcnt lgkmcnt(13)
    v_mfma_f32_16x16x32_bf16 v[24:27], v[120:123], v[56:59], v[24:27]
    v_perm_b32 v120, v18, v18, v112
    v_perm_b32 v121, v18, v18, v113
    v_perm_b32 v122, v18, v18, v114
    v_perm_b32 v123, v18, v18, v115
    s_waitcnt lgkmcnt(12)
    v_mfma_f32_16x16x32_bf16 v[24:27], v[124:127], v[60:63], v[24:27]
    v_perm_b32 v124, v18, v18, v116
    v_perm_b32 v125, v18, v18, v117
    v_perm_b32 v126, v18, v18, v118
    v_perm_b32 v127, v18, v18, v119
    s_waitcnt lgkmcnt(11)
    v_mfma_f32_16x16x32_bf16 v[24:27], v[120:123], v[64:67], v[24:27]
    v_perm_b32 v120, v19, v19, v112
    v_perm_b32 v121, v19, v19, v113
    v_perm_b32 v122, v19, v19, v114
    v_perm_b32 v123, v19, v19, v115
    s_waitcnt lgkmcnt(10)
    v_mfma_f32_16x16x32_bf16 v[24:27], v[124:127], v[68:71], v[24:27]
    v_perm_b32 v124, v19, v19, v116
    v_perm_b32 v125, v19, v19, v117
    v_perm_b32 v126, v19, v19, v118
    v_perm_b32 v127, v19, v19, v119
    s_waitcnt lgkmcnt(9)
    v_mfma_f32_16x16x32_bf16 v[24:27], v[120:123], v[72:75], v[24:27]
    v_perm_b32 v120, v20, v20, v112
    v_perm_b32 v121, v20, v20, v113
    v_perm_b32 v122, v20, v20, v114
    v_perm_b32 v123, v20, v20, v115
    s_waitcnt lgkmcnt(8)
    v_mfma_f32_16x16x32_bf16 v[24:27], v[124:127], v[76:79], v[24:27]
    v_perm_b32 v124, v20, v20, v116
    v_perm_b32 v125, v20, v20, v117
    v_perm_b32 v126, v20, v20, v118
    v_perm_b32 v127, v20, v20, v119
    s_waitcnt lgkmcnt(7)
    v_mfma_f32_16x16x32_bf16 v[24:27], v[120:123], v[80:83], v[24:27]
    v_perm_b32 v120, v21, v21, v112
    v_perm_b32 v121, v21, v21, v113
    v_perm_b32 v122, v21, v21, v114
    v_perm_b32 v123, v21, v21, v115
    s_waitcnt lgkmcnt(6)
    v_mfma_f32_16x16x32_bf16 v[24:27], v[124:127], v[84:87], v[24:27]
    v_perm_b32 v124, v21, v21, v116
    v_perm_b32 v125, v21, v21, v117
    v_perm_b32 v126, v21, v21, v118
    v_perm_b32 v127, v21, v21, v119
    s_waitcnt lgkmcnt(5)
    v_mfma_f32_16x16x32_bf16 v[24:27], v[120:123], v[88:91], v[24:27]
    v_perm_b32 v120, v22, v22, v112
    v_perm_b32 v121, v22, v22, v113
    v_perm_b32 v122, v22, v22, v114
    v_perm_b32 v123, v22, v22, v115
    s_waitcnt lgkmcnt(4)
    v_mfma_f32_16x16x32_bf16 v[24:27], v[124:127], v[92:95], v[24:27]
    v_perm_b32 v124, v22, v22, v116
    v_perm_b32 v125, v22, v22, v117
    v_perm_b32 v126, v22, v22, v118
    v_perm_b32 v127, v22, v22, v119
    s_waitcnt lgkmcnt(3)
    v_mfma_f32_16x16x32_bf16 v[24:27], v[120:123], v[96:99], v[24:27]
    v_perm_b32 v120, v23, v23, v112
    v_perm_b32 v121, v23, v23, v113
    v_perm_b32 v122, v23, v23, v114
    v_perm_b32 v123, v23, v23, v115
    s_waitcnt lgkmcnt(2)
    v_mfma_f32_16x16x32_bf16 v[24:27], v[124:127], v[100:103], v[24:27]
    v_perm_b32 v124, v23, v23, v116
    v_perm_b32 v125, v23, v23, v117
    v_perm_b32 v126, v23, v23, v118
    v_perm_b32 v127, v23, v23, v119
    s_waitcnt lgkmcnt(1)
    v_mfma_f32_16x16x32_bf16 v[24:27], v[120:123], v[104:107], v[24:27]
    s_nop 0
    s_waitcnt lgkmcnt(0)
    v_mfma_f32_16x16x32_bf16 v[24:27], v[124:127], v[108:111], v[24:27]
    s_mov_b32 s59, 65536
    s_nop 6
    v_perm_b32 v24, v24, v7, s62
    v_perm_b32 v25, v25, v7, s63
    v_perm_b32 v26, v26, v7, s64
    v_perm_b32 v27, v27, v7, s65
    global_store_dwordx4 v6, v[24:27], s[60:61]
    global_load_dwordx4 v[48:51], v4, s[60:61] offset:-4096 sc0 sc1
    global_load_dwordx4 v[52:55], v4, s[60:61] offset:-2048 sc0 sc1
    global_load_dwordx4 v[56:59], v4, s[60:61] offset:0 sc0 sc1
    global_load_dwordx4 v[60:63], v4, s[60:61] offset:2048 sc0 sc1
    s_add_u32 s36, s40, s41
    s_add_u32 s36, s36, 393216
    s_add_u32 s44, s28, s36
    s_addc_u32 s45, s29, 0
    s_add_u32 s46, s44, 2097152
    s_addc_u32 s47, s45, 0
    s_lshr_b32 s36, s35, 3
    s_lshl4_add_u32 s36, s33, s36
    s_lshl_b32 s36, s36, 12
    s_and_b32 s38, s35, 7
    s_lshl4_add_u32 s36, s38, s36
    s_add_u32 s36, s36, 655360
    s_add_u32 s56, s28, s36
    s_addc_u32 s57, s29, 0
    v_and_b32 v8, 15, v0
    v_lshlrev_b32 v8, 4, v8
    v_bfe_u32 v41, v0, 4, 1
    v_lshl_or_b32 v8, v41, 3, v8
    v_lshrrev_b32 v42, 5, v0
    v_lshl_or_b32 v8, v42, 2, v8
    v_and_b32 v41, 32, v0
    v_lshlrev_b32 v9, 6, v41
    v_and_b32 v42, 31, v0
    v_lshl_or_b32 v15, v42, 4, v9
    v_lshl_or_b32 v9, v42, 3, v9
    v_add_u32 v9, 2048, v9
    v_and_b32 v13, 3, v0
    v_lshl_or_b32 v13, v13, 3, v41
    v_lshlrev_b32 v11, 7, v0
    v_lshrrev_b32 v12, 4, v0
    v_lshlrev_b32 v12, 2, v12
    v_mov_b32 v14, 1
L_qloop:
    s_and_b32 s36, s59, 7
    s_cmp_eq_u32 s36, 1
    s_cselect_b32 s38, s54, s60
    s_cselect_b32 s39, s55, s61
    s_cbranch_scc0 L_qns
    global_store_dwordx4 v6, v[24:27], s[54:55] sc0 sc1
L_qns:
    global_load_dwordx4 v[64:67], v4, s[38:39] offset:-4096 sc0 sc1
    global_load_dwordx4 v[68:71], v4, s[38:39] offset:-2048 sc0 sc1
    global_load_dwordx4 v[72:75], v4, s[38:39] offset:0 sc0 sc1
    global_load_dwordx4 v[76:79], v4, s[38:39] offset:2048 sc0 sc1
    s_waitcnt vmcnt(4)
    v_perm_b32 v40, v49, v48, s66
    v_perm_b32 v41, v51, v50, s67
    v_perm_b32 v42, v53, v52, s66
    v_perm_b32 v43, v55, v54, s67
    v_perm_b32 v44, v57, v56, s66
    v_perm_b32 v45, v59, v58, s67
    v_perm_b32 v46, v61, v60, s66
    v_perm_b32 v47, v63, v62, s67
    v_bitop3_b32 v40, v40, v41, v7 bitop3:0x56
    v_bitop3_b32 v42, v42, v43, v7 bitop3:0x56
    v_bitop3_b32 v44, v44, v45, v7 bitop3:0x56
    v_bitop3_b32 v46, v46, v47, v7 bitop3:0x56
    v_or3_b32 v40, v40, v42, v44
    v_or_b32 v40, v40, v46
    v_cmp_ne_u32 vcc, 0, v40
    s_cbranch_vccz L_qgotA
    global_load_dwordx4 v[48:51], v4, s[60:61] offset:-4096 sc0 sc1
    global_load_dwordx4 v[52:55], v4, s[60:61] offset:-2048 sc0 sc1
    global_load_dwordx4 v[56:59], v4, s[60:61] offset:0 sc0 sc1
    global_load_dwordx4 v[60:63], v4, s[60:61] offset:2048 sc0 sc1
    s_waitcnt vmcnt(4)
    v_perm_b32 v40, v65, v64, s66
    v_perm_b32 v41, v67, v66, s67
    v_perm_b32 v42, v69, v68, s66
    v_perm_b32 v43, v71, v70, s67
    v_perm_b32 v44, v73, v72, s66
    v_perm_b32 v45, v75, v74, s67
    v_perm_b32 v46, v77, v76, s66
    v_perm_b32 v47, v79, v78, s67
    v_bitop3_b32 v40, v40, v41, v7 bitop3:0x56
    v_bitop3_b32 v42, v42, v43, v7 bitop3:0x56
    v_bitop3_b32 v44, v44, v45, v7 bitop3:0x56
    v_bitop3_b32 v46, v46, v47, v7 bitop3:0x56
    v_or3_b32 v40, v40, v42, v44
    v_or_b32 v40, v40, v46
    v_cmp_ne_u32 vcc, 0, v40
    s_cbranch_vccz L_qgotB
    s_sub_u32 s59, s59, 1
    s_cbranch_scc0 L_qloop
L_qgotB:
    v_pk_add_f32 v[28:29], v[64:65], v[68:69]
    v_pk_add_f32 v[32:33], v[72:73], v[76:77]
    v_pk_add_f32 v[30:31], v[66:67], v[70:71]
    v_pk_add_f32 v[34:35], v[74:75], v[78:79]
    s_branch L_qsum
L_qgotA:
    v_pk_add_f32 v[28:29], v[48:49], v[52:53]
    v_pk_add_f32 v[32:33], v[56:57], v[60:61]
    v_pk_add_f32 v[30:31], v[50:51], v[54:55]
    v_pk_add_f32 v[34:35], v[58:59], v[62:63]
L_qsum:
    v_pk_add_f32 v[28:29], v[28:29], v[32:33]
    v_pk_add_f32 v[30:31], v[30:31], v[34:35]
    s_mov_b32 s68, -1
    s_mov_b32 s69, 1
    v_permlane32_swap_b32 v28, v30
    v_permlane32_swap_b32 v29, v31
    v_pk_add_f32 v[28:29], v[28:29], v[30:31]
    v_cvt_pk_bf16_f32 v28, v28, v29
    ds_write_b32 v8, v28 offset:0
    s_mov_b64 exec, 1
    ds_write_b32 v136, v14 offset:256
    s_mov_b64 exec, -1
    global_store_dwordx4 v6, v[24:27], s[54:55] sc0 sc1
    s_add_u32 s36, s40, 2490368
    v_add_u32 v41, s36, v11
    global_load_dword v138, v41, s[28:29] sc0 sc1
L_mlw:
    ds_read_b64 v[44:45], v13 offset:384
    s_waitcnt lgkmcnt(0)
    v_cmp_eq_u32 vcc, 0, v45
    s_cbranch_vccnz L_mlw
    v_max_f32_dpp v26, v44, v44 quad_perm:[1,0,3,2] row_mask:0xf bank_mask:0xf
    s_nop 1
    v_max_f32_dpp v26, v26, v26 quad_perm:[2,3,0,1] row_mask:0xf bank_mask:0xf
    v_mov_b32 v46, v26
    s_nop 1
    v_permlane32_swap_b32 v26, v46
    v_max_f32 v26, v26, v46
    v_sub_f32 v46, v44, v26
    v_mul_f32 v46, 0x3fb8aa3b, v46
    v_exp_f32 v46, v46
    s_nop 0
    v_mul_f32 v27, v45, v46
    s_nop 1
    v_add_f32_dpp v27, v27, v27 quad_perm:[1,0,3,2] row_mask:0xf bank_mask:0xf
    s_nop 1
    v_add_f32_dpp v27, v27, v27 quad_perm:[2,3,0,1] row_mask:0xf bank_mask:0xf
    v_mov_b32 v44, v27
    s_nop 1
    v_permlane32_swap_b32 v27, v44
    v_add_f32 v27, v27, v44
    v_perm_b32 v26, v26, v7, s64
    v_perm_b32 v27, v27, v7, s65
    s_barrier
    ds_read2_b64 v[112:115], v9 offset0:0 offset1:32
    ds_read2_b64 v[116:119], v9 offset0:64 offset1:96
    ds_read2_b64 v[120:123], v9 offset0:128 offset1:160
    ds_read2_b64 v[124:127], v9 offset0:192 offset1:224
    ds_read_b32 v40, v12 offset:320
    ds_read_b32 v41, v12 offset:336
    ds_read_b32 v42, v12 offset:352
    s_waitcnt lgkmcnt(6)
    v_mul_f32_dpp v16, v46, v112 quad_perm:[0,0,0,0] row_mask:0xf bank_mask:0xf
    v_mul_f32_dpp v17, v46, v113 quad_perm:[0,0,0,0] row_mask:0xf bank_mask:0xf
    v_mul_f32_dpp v18, v46, v114 quad_perm:[0,0,0,0] row_mask:0xf bank_mask:0xf
    v_mul_f32_dpp v19, v46, v115 quad_perm:[0,0,0,0] row_mask:0xf bank_mask:0xf
    s_waitcnt lgkmcnt(5)
    v_fmac_f32_dpp v16, v46, v116 quad_perm:[1,1,1,1] row_mask:0xf bank_mask:0xf
    v_fmac_f32_dpp v17, v46, v117 quad_perm:[1,1,1,1] row_mask:0xf bank_mask:0xf
    v_fmac_f32_dpp v18, v46, v118 quad_perm:[1,1,1,1] row_mask:0xf bank_mask:0xf
    v_fmac_f32_dpp v19, v46, v119 quad_perm:[1,1,1,1] row_mask:0xf bank_mask:0xf
    s_waitcnt lgkmcnt(4)
    v_fmac_f32_dpp v16, v46, v120 quad_perm:[2,2,2,2] row_mask:0xf bank_mask:0xf
    v_fmac_f32_dpp v17, v46, v121 quad_perm:[2,2,2,2] row_mask:0xf bank_mask:0xf
    v_fmac_f32_dpp v18, v46, v122 quad_perm:[2,2,2,2] row_mask:0xf bank_mask:0xf
    v_fmac_f32_dpp v19, v46, v123 quad_perm:[2,2,2,2] row_mask:0xf bank_mask:0xf
    s_waitcnt lgkmcnt(3)
    v_fmac_f32_dpp v16, v46, v124 quad_perm:[3,3,3,3] row_mask:0xf bank_mask:0xf
    v_fmac_f32_dpp v17, v46, v125 quad_perm:[3,3,3,3] row_mask:0xf bank_mask:0xf
    v_fmac_f32_dpp v18, v46, v126 quad_perm:[3,3,3,3] row_mask:0xf bank_mask:0xf
    v_fmac_f32_dpp v19, v46, v127 quad_perm:[3,3,3,3] row_mask:0xf bank_mask:0xf
    s_nop 1
    v_permlane32_swap_b32 v16, v18
    v_permlane32_swap_b32 v17, v19
    v_pk_add_f32 v[24:25], v[16:17], v[18:19]
    v_perm_b32 v24, v24, v7, s62
    v_perm_b32 v25, v25, v7, s63
    global_store_dwordx4 v137, v[24:27], s[46:47]
    s_barrier
    global_store_dwordx4 v137, v[24:27], s[44:45] sc0 sc1
    s_waitcnt lgkmcnt(0)
    v_add_f32 v40, v40, v41
    v_add_f32 v40, v40, v42
    v_cvt_pk_bf16_f32 v40, v40, v40
    v_and_b32 v40, s58, v40
    v_add_f32 v40, v40, v2
    v_cvt_pk_bf16_f32 v40, v40, v40
    v_and_b32 v40, s58, v40
    v_mul_f32 v41, 0xbfb8aa3b, v40
    v_exp_f32 v41, v41
    s_nop 0
    v_add_f32 v41, 1.0, v41
    v_rcp_f32 v41, v41
    s_nop 0
    v_mul_f32 v2, v40, v41
    v_cvt_pk_bf16_f32 v2, v2, v2
    v_and_b32 v2, s58, v2
    s_mov_b32 s59, 65536
    s_mov_b32 s50, -1
    s_mov_b32 s51, 0
    s_mov_b32 s68, 0x00010001
    s_mov_b32 s69, s68
    s_barrier
    s_mov_b64 exec, s[50:51]
    s_barrier
    global_load_dwordx4 v[80:83], v11, s[56:57] sc0 sc1
L_yloop:
    s_waitcnt vmcnt(0)
    v_perm_b32 v40, v81, v80, s66
    v_perm_b32 v41, v83, v82, s67
    v_bitop3_b32 v40, v40, v41, v7 bitop3:0x56
    v_cmp_ne_u32 vcc, 0, v40
    s_cbranch_vccz L_ysum
    s_mov_b64 exec, vcc
    s_sub_u32 s59, s59, 1
    s_cbranch_scc1 L_ysum
    global_load_dwordx4 v[80:83], v11, s[56:57] sc0 sc1
    s_branch L_yloop
L_ysum:
    s_mov_b64 exec, -1
    v_permlane32_swap_b32 v80, v82
    v_permlane32_swap_b32 v81, v83
    s_nop 1
    v_permlane16_swap_b32 v80, v81
    v_add_f32 v80, v80, v81
    s_nop 1
    v_add_f32_dpp v80, v80, v80 row_ror:8 row_mask:0xf bank_mask:0xf
    s_nop 1
    v_add_f32_dpp v80, v80, v80 row_ror:4 row_mask:0xf bank_mask:0xf
    s_nop 1
    v_add_f32_dpp v80, v80, v80 row_ror:2 row_mask:0xf bank_mask:0xf
    s_nop 1
    v_add_f32_dpp v80, v80, v80 row_ror:1 row_mask:0xf bank_mask:0xf
    v_cvt_pk_bf16_f32 v80, v80, v80
    v_and_b32 v80, s58, v80
    v_mul_f32 v80, v80, v2
    v_cvt_pk_bf16_f32 v80, v80, v80
    v_and_b32 v80, s58, v80
    v_add_f32 v80, v80, v1
    v_cvt_pk_bf16_f32 v80, v80, v80
    s_mov_b64 exec, s[68:69]
    global_store_short v3, v80, s[24:25]
    s_cmp_eq_u32 s2, 0
    s_cbranch_scc0 L_fin
    s_mov_b64 exec, 1
    v_mov_b32 v41, s37
    global_store_dword v136, v41, s[28:29]
L_fin:
L_end:
    s_endpgm
L_s2:
    global_load_dwordx4 v[12:15], v1, s[6:7] offset:-3072 nt
    s_load_dwordx2 s[28:29], s[0:1], 96
    v_lshlrev_b32 v2, 6, v3
    v_lshl_or_b32 v2, v4, 4, v2
    v_lshl_add_u32 v2, s34, 7, v2
    s_lshl1_add_u32 s36, s30, -1
    s_lshl_b32 s36, s36, 16
    s_lshl_b32 s38, s3, 8
    s_add_u32 s36, s36, s38
    s_lshl_b32 s38, s42, 7
    s_add_u32 s36, s36, s38
    v_and_b32 v7, 56, v0
    v_lshlrev_b32 v116, 8, v7
    v_and_b32 v7, 7, v0
    v_lshl_or_b32 v116, v7, 4, v116
    v_add_u32 v116, s36, v116
    v_lshlrev_b32 v121, 5, v7
    v_and_b32 v7, 8, v0
    v_lshl_or_b32 v121, v7, 1, v121
    v_lshrrev_b32 v7, 2, v3
    v_or_b32 v121, v7, v121
    s_lshl_b32 s36, s3, 3
    s_add_u32 s36, s36, 6144
    v_add_u32 v121, s36, v121
    s_mov_b32 s16, 0x05040100
    s_mov_b32 s17, 0x07060302
    s_mov_b32 s40, 0x000f000f
    s_mov_b32 s41, s40
    s_lshl_b64 s[42:43], s[40:41], 4
    s_lshl_b64 s[44:45], s[40:41], 8
    s_lshl_b64 s[46:47], s[40:41], 12
    v_and_b32 v7, 1, v0
    v_lshlrev_b32 v120, 10, v7
    v_lshlrev_b32 v7, 4, v7
    v_mov_b32 v5, 0xffff
    v_lshlrev_b32 v5, v7, v5
    v_cndmask_b32 v112, 0, v5, s[40:41]
    v_cndmask_b32 v113, 0, v5, s[42:43]
    v_cndmask_b32 v114, 0, v5, s[44:45]
    v_cndmask_b32 v115, 0, v5, s[46:47]
    v_mov_b64 v[88:89], 0
    v_mov_b64 v[90:91], 0
    v_mov_b64 v[92:93], 0
    v_mov_b64 v[94:95], 0
    v_mov_b64 v[96:97], 0
    v_mov_b64 v[98:99], 0
    v_mov_b64 v[100:101], 0
    v_mov_b64 v[102:103], 0
    v_lshlrev_b32 v117, 2, v3
    v_and_b32 v7, 3, v0
    v_lshl_or_b32 v117, v7, 4, v117
    v_lshrrev_b32 v7, 1, v3
    v_lshl_or_b32 v118, v4, 5, v7
    s_lshl_b32 s36, s3, 3
    v_add_u32 v118, s36, v118
    v_and_b32 v7, 12, v0
    v_lshl_or_b32 v120, v7, 9, v120
    v_and_b32 v7, 0x3f0, v0
    v_lshl_add_u32 v119, v7, 1, v120
    v_and_b32 v7, 2, v0
    v_lshl_or_b32 v119, v7, 3, v119
    v_lshrrev_b32 v7, 6, v0
    v_lshlrev_b32 v7, 3, v7
    s_mov_b32 s58, 0xffff0000
    s_mov_b32 s62, 0x07060500
    s_mov_b32 s63, 0x07060501
    s_mov_b32 s64, 0x07060502
    s_mov_b32 s65, 0x07060503
    s_mov_b32 s66, 0x0c0c0400
    s_mov_b32 s67, 0x04000c0c
    v_mov_b32 v6, 0
    v_mov_b32 v128, 1
    s_mov_b32 s48, 0x3db504f3
    s_mov_b32 s50, 0x3fb8aa3b
    s_mov_b32 s59, 2097152
    v_and_b32 v135, 7, v0
    v_lshlrev_b32 v135, 4, v135
    v_lshl_or_b32 v134, v3, 3, v135
    v_and_b32 v5, 8, v0
    v_lshl_or_b32 v134, v5, 8, v134
    v_and_b32 v5, 32, v0
    v_lshl_or_b32 v135, v5, 11, v135
    v_and_b32 v5, 16, v0
    v_lshl_or_b32 v135, v5, 8, v135
    s_mov_b32 s68, 0x00ff00ff
    s_mov_b32 s69, s68
    s_lshr_b32 s36, s2, 5
    s_lshl_b32 s36, s36, 13
    s_lshl_b32 s38, s30, 7
    s_add_u32 s36, s36, s38
    s_add_u32 s36, s36, 655360
    s_waitcnt lgkmcnt(0)
    s_add_u32 s56, s28, s36
    s_addc_u32 s57, s29, 0
    s_lshl_b32 s36, s30, 13
    s_add_u32 s36, s36, 393216
    s_waitcnt lgkmcnt(0)
    s_add_u32 s54, s28, s36
    s_addc_u32 s55, s29, 0
    s_add_u32 s60, s54, 2097152
    s_addc_u32 s61, s55, 0
    s_waitcnt vmcnt(3)
    global_load_dwordx4 v[16:19], v1, s[6:7] offset:-2048 nt
    s_waitcnt vmcnt(3)
    global_load_dwordx4 v[20:23], v1, s[6:7] offset:-1024 nt
    s_barrier
    s_waitcnt vmcnt(3)
    global_load_dwordx4 v[24:27], v1, s[6:7] offset:0 nt
    s_waitcnt vmcnt(3)
    global_load_dwordx4 v[28:31], v1, s[6:7] offset:1024 nt
    s_waitcnt vmcnt(3)
    global_load_dwordx4 v[32:35], v1, s[6:7] offset:2048 nt
    s_waitcnt vmcnt(3)
    global_load_dwordx4 v[36:39], v1, s[6:7] offset:3072 nt
    s_waitcnt vmcnt(3)
    global_load_dwordx4 v[40:43], v2, s[8:9] offset:-4096 nt
    s_waitcnt vmcnt(3)
    global_load_dwordx4 v[44:47], v2, s[8:9] offset:-3840 nt
    s_waitcnt vmcnt(3)
    global_load_dwordx4 v[48:51], v2, s[8:9] offset:-3584 nt
    ds_read_b32 v123, v6 offset:256
    s_waitcnt vmcnt(3)
    global_load_dwordx4 v[52:55], v2, s[8:9] offset:-3328 nt
    s_waitcnt lgkmcnt(0)
    v_cmp_eq_u32 vcc, v123, v128
    s_cbranch_vccz L_skip0
    s_call_b64 s[14:15], L_qk
L_skip0:
    ds_read_b32 v123, v6 offset:256
    s_waitcnt vmcnt(3)
    global_load_dwordx4 v[56:59], v2, s[8:9] offset:0 nt
    s_waitcnt lgkmcnt(0)
    v_cmp_eq_u32 vcc, v123, v128
    s_cbranch_vccz L_skip1
    s_call_b64 s[14:15], L_qk
L_skip1:
    ds_read_b32 v123, v6 offset:256
    s_waitcnt vmcnt(3)
    global_load_dwordx4 v[60:63], v2, s[8:9] offset:256 nt
    s_waitcnt lgkmcnt(0)
    v_cmp_eq_u32 vcc, v123, v128
    s_cbranch_vccz L_skip2
    s_call_b64 s[14:15], L_qk
L_skip2:
    ds_read_b32 v123, v6 offset:256
    s_waitcnt vmcnt(3)
    global_load_dwordx4 v[64:67], v2, s[8:9] offset:512 nt
    s_waitcnt lgkmcnt(0)
    v_cmp_eq_u32 vcc, v123, v128
    s_cbranch_vccz L_skip3
    s_call_b64 s[14:15], L_qk
L_skip3:
    ds_read_b32 v123, v6 offset:256
    s_waitcnt vmcnt(3)
    global_load_dwordx4 v[68:71], v2, s[8:9] offset:768 nt
    s_waitcnt lgkmcnt(0)
    v_cmp_eq_u32 vcc, v123, v128
    s_cbranch_vccz L_skip4
    s_call_b64 s[14:15], L_qk
L_skip4:
    ds_read_b32 v123, v6 offset:256
    s_waitcnt vmcnt(3)
    global_load_dwordx4 v[72:75], v116, s[12:13] offset:0 nt
    s_waitcnt lgkmcnt(0)
    v_cmp_eq_u32 vcc, v123, v128
    s_cbranch_vccz L_skip5
    s_call_b64 s[14:15], L_qk
L_skip5:
    ds_read_b32 v123, v6 offset:256
    s_waitcnt vmcnt(3)
    global_load_dwordx4 v[76:79], v116, s[12:13] offset:1024 nt
    s_waitcnt lgkmcnt(0)
    v_cmp_eq_u32 vcc, v123, v128
    s_cbranch_vccz L_skip6
    s_call_b64 s[14:15], L_qk
L_skip6:
    v_cmp_eq_u32 vcc, 1, v128
    s_cbranch_vccz L_pv
L_fspin:
    ds_read_b32 v123, v6 offset:256
    s_waitcnt lgkmcnt(0)
    v_cmp_eq_u32 vcc, 1, v123
    s_cbranch_vccnz L_fgot
    s_sub_u32 s59, s59, 1
    s_cbranch_scc0 L_fspin
L_fgot:
    s_call_b64 s[14:15], L_qk
L_pv:
    v_mfma_f32_16x16x32_bf16 v[88:91], v[8:11], v[40:43], 0
    v_mfma_f32_16x16x32_bf16 v[92:95], v[12:15], v[44:47], 0
    v_mfma_f32_16x16x32_bf16 v[88:91], v[16:19], v[48:51], v[88:91]
    v_mfma_f32_16x16x32_bf16 v[92:95], v[20:23], v[52:55], v[92:95]
    v_mfma_f32_16x16x32_bf16 v[88:91], v[24:27], v[56:59], v[88:91]
    v_mfma_f32_16x16x32_bf16 v[92:95], v[28:31], v[60:63], v[92:95]
    s_waitcnt vmcnt(3)
    v_mfma_f32_16x16x32_bf16 v[88:91], v[32:35], v[64:67], v[88:91]
    s_waitcnt vmcnt(2)
    v_mfma_f32_16x16x32_bf16 v[92:95], v[36:39], v[68:71], v[92:95]
    s_mov_b32 s59, 65536
    s_nop 6
    v_pk_add_f32 v[88:89], v[88:89], v[92:93]
    ds_write_b64 v118, v[88:89] offset:0
    s_waitcnt lgkmcnt(0)
    s_barrier
    s_barrier
    global_load_dwordx4 v[40:43], v119, s[60:61] offset:-512 sc0 sc1
    s_waitcnt vmcnt(1)
    v_perm_b32 v16, v76, v72, s16
    v_perm_b32 v17, v76, v72, s17
    v_perm_b32 v18, v77, v73, s16
    v_perm_b32 v19, v77, v73, s17
    v_perm_b32 v20, v78, v74, s16
    v_perm_b32 v21, v78, v74, s17
    v_perm_b32 v22, v79, v75, s16
    v_perm_b32 v23, v79, v75, s17
    s_movk_i32 s36, 24
L_opoll:
    global_load_dwordx4 v[40:43], v119, s[60:61] offset:-512 sc0 sc1
    s_waitcnt vmcnt(1)
    v_perm_b32 v124, v41, v40, s66
    v_perm_b32 v125, v43, v42, s67
    v_bitop3_b32 v124, v124, v125, v122 bitop3:0x56
    v_cmp_ne_u32 vcc, 0, v124
    s_cbranch_vccz L_ogot
    s_mov_b64 exec, vcc
    s_sub_u32 s36, s36, 1
    s_cbranch_scc0 L_opoll
    s_waitcnt vmcnt(0)
L_oslow:
    s_bitcmp0_b32 s59, 0
    s_cselect_b32 s38, s54, s60
    s_cselect_b32 s39, s55, s61
    global_load_dwordx4 v[40:43], v119, s[38:39] offset:-512 sc0 sc1
    s_waitcnt vmcnt(0)
    v_perm_b32 v124, v41, v40, s66
    v_perm_b32 v125, v43, v42, s67
    v_bitop3_b32 v124, v124, v125, v122 bitop3:0x56
    v_cmp_ne_u32 vcc, 0, v124
    s_cbranch_vccz L_ogot
    s_mov_b64 exec, vcc
    s_sub_u32 s59, s59, 1
    s_cbranch_scc0 L_oslow
L_ogot:
    s_mov_b64 exec, -1
    v_and_b32 v58, s58, v42
    s_nop 1
    v_max_f32_dpp v3, v58, v58 row_ror:4 row_mask:0xf bank_mask:0xf
    s_nop 1
    v_max_f32_dpp v3, v3, v3 row_ror:8 row_mask:0xf bank_mask:0xf
    v_sub_f32 v58, v58, v3
    v_mul_f32 v58, s50, v58
    v_exp_f32 v58, v58
    s_nop 0
    v_mul_f32 v59, v43, v58
    v_pk_mul_f32 v[56:57], v[40:41], v[58:59] op_sel_hi:[1,0]
    s_nop 0
    v_add_f32_dpp v59, v59, v59 row_ror:4 row_mask:0xf bank_mask:0xf
    v_add_f32_dpp v56, v56, v56 row_ror:4 row_mask:0xf bank_mask:0xf
    v_add_f32_dpp v57, v57, v57 row_ror:4 row_mask:0xf bank_mask:0xf
    v_add_f32_dpp v59, v59, v59 row_ror:8 row_mask:0xf bank_mask:0xf
    v_rcp_f32 v58, v59
    v_add_f32_dpp v56, v56, v56 row_ror:8 row_mask:0xf bank_mask:0xf
    v_add_f32_dpp v57, v57, v57 row_ror:8 row_mask:0xf bank_mask:0xf
    v_pk_mul_f32 v[56:57], v[56:57], v[58:59] op_sel_hi:[1,0]
    v_cvt_pk_bf16_f32 v56, v56, v57
    v_cndmask_b32 v8, 0, v56, s[40:41]
    v_cndmask_b32 v9, 0, v56, s[42:43]
    v_cndmask_b32 v10, 0, v56, s[44:45]
    v_cndmask_b32 v11, 0, v56, s[46:47]
    s_nop 1
    v_mfma_f32_16x16x32_bf16 v[104:107], v[8:11], v[16:19], 0
    v_mfma_f32_16x16x32_bf16 v[108:111], v[8:11], v[20:23], 0
    s_nop 6
    v_add_f32_dpp v56, v106, v104 row_ror:8 row_mask:0xf bank_mask:0x3
    v_add_f32_dpp v57, v107, v105 row_ror:8 row_mask:0xf bank_mask:0x3
    s_nop 0
    v_add_f32_dpp v56, v108, v110 row_ror:8 row_mask:0xf bank_mask:0xc
    v_add_f32_dpp v57, v109, v111 row_ror:8 row_mask:0xf bank_mask:0xc
    ds_write2_b32 v121, v56, v57 offset0:0 offset1:64
    s_waitcnt lgkmcnt(0)
    s_cmp_lg_u32 s3, 256
    s_barrier
    s_cbranch_scc1 L_send
    ds_read_b128 v[8:11], v134 offset:8192
    ds_read_b128 v[12:15], v134 offset:8704
    ds_read_b128 v[16:19], v134 offset:9216
    ds_read_b128 v[20:23], v134 offset:9728
    s_waitcnt lgkmcnt(2)
    v_pk_add_f32 v[24:25], v[8:9], v[12:13]
    v_pk_add_f32 v[26:27], v[10:11], v[14:15]
    s_waitcnt lgkmcnt(0)
    v_pk_add_f32 v[16:17], v[16:17], v[20:21]
    v_pk_add_f32 v[18:19], v[18:19], v[22:23]
    v_pk_add_f32 v[24:25], v[24:25], v[16:17]
    v_pk_add_f32 v[26:27], v[26:27], v[18:19]
    s_nop 0
    v_add_f32_dpp v28, v24, v24 row_ror:8 row_mask:0xf bank_mask:0xf
    v_add_f32_dpp v29, v25, v25 row_ror:8 row_mask:0xf bank_mask:0xf
    v_add_f32_dpp v30, v26, v26 row_ror:8 row_mask:0xf bank_mask:0xf
    v_add_f32_dpp v31, v27, v27 row_ror:8 row_mask:0xf bank_mask:0xf
    s_mov_b64 exec, s[68:69]
    v_perm_b32 v28, v28, v122, s62
    v_perm_b32 v29, v29, v122, s63
    v_perm_b32 v30, v30, v122, s64
    v_perm_b32 v31, v31, v122, s65
    global_store_dwordx4 v135, v[28:31], s[56:57] sc0 sc1
    s_waitcnt vmcnt(0)
    s_barrier
L_send:
    s_endpgm
L_qk:
    s_mov_b64 exec, s[40:41]
    ds_read_b128 v[88:91], v117 offset:0
    s_mov_b64 exec, s[42:43]
    ds_read_b128 v[92:95], v117 offset:0
    s_mov_b64 exec, s[44:45]
    ds_read_b128 v[96:99], v117 offset:0
    s_mov_b64 exec, s[46:47]
    ds_read_b128 v[100:103], v117 offset:0
    s_mov_b64 exec, -1
    ds_read_b32 v122, v6 offset:260
    v_mov_b32 v128, 2
    s_waitcnt lgkmcnt(4)
    v_mfma_f32_16x16x32_bf16 v[104:107], v[88:91], v[8:11], 0
    v_mfma_f32_16x16x32_bf16 v[108:111], v[88:91], v[24:27], 0
    s_waitcnt lgkmcnt(3)
    v_mfma_f32_16x16x32_bf16 v[104:107], v[92:95], v[12:15], v[104:107]
    v_mfma_f32_16x16x32_bf16 v[108:111], v[92:95], v[28:31], v[108:111]
    s_waitcnt lgkmcnt(2)
    v_mfma_f32_16x16x32_bf16 v[104:107], v[96:99], v[16:19], v[104:107]
    v_mfma_f32_16x16x32_bf16 v[108:111], v[96:99], v[32:35], v[108:111]
    s_waitcnt lgkmcnt(1)
    v_mfma_f32_16x16x32_bf16 v[104:107], v[100:103], v[20:23], v[104:107]
    v_mfma_f32_16x16x32_bf16 v[108:111], v[100:103], v[36:39], v[108:111]
    s_nop 6
    v_mov_b32_dpp v130, v104 quad_perm:[0,0,0,0] row_mask:0xf bank_mask:0xf
    v_mov_b32_dpp v131, v108 quad_perm:[0,0,0,0] row_mask:0xf bank_mask:0xf
    v_add_f32_dpp v130, v105, v130 quad_perm:[1,1,1,1] row_mask:0xf bank_mask:0xf
    v_add_f32_dpp v131, v109, v131 quad_perm:[1,1,1,1] row_mask:0xf bank_mask:0xf
    v_add_f32_dpp v130, v106, v130 quad_perm:[2,2,2,2] row_mask:0xf bank_mask:0xf
    v_add_f32_dpp v131, v110, v131 quad_perm:[2,2,2,2] row_mask:0xf bank_mask:0xf
    v_add_f32_dpp v130, v107, v130 quad_perm:[3,3,3,3] row_mask:0xf bank_mask:0xf
    v_add_f32_dpp v131, v111, v131 quad_perm:[3,3,3,3] row_mask:0xf bank_mask:0xf
    v_cvt_pk_bf16_f32 v3, v130, v131
    v_lshlrev_b32 v130, 16, v3
    v_and_b32 v131, s58, v3
    v_pk_mul_f32 v[130:131], v[130:131], s[48:49] op_sel_hi:[1,0]
    v_cvt_pk_bf16_f32 v3, v130, v131
    v_lshlrev_b32 v130, 16, v3
    v_and_b32 v131, s58, v3
    v_max_f32 v132, v130, v131
    s_nop 1
    v_max_f32_dpp v132, v132, v132 row_ror:4 row_mask:0xf bank_mask:0xf
    s_nop 1
    v_max_f32_dpp v132, v132, v132 row_ror:8 row_mask:0xf bank_mask:0xf
    v_mov_b32 v4, v132
    s_nop 1
    v_permlane16_swap_b32 v132, v4
    v_max_f32 v132, v132, v4
    v_mov_b32 v4, v132
    s_nop 1
    v_permlane32_swap_b32 v132, v4
    v_max_f32 v132, v132, v4
    v_pk_add_f32 v[130:131], v[130:131], v[132:133] op_sel_hi:[1,0] neg_lo:[0,1] neg_hi:[0,1]
    v_pk_mul_f32 v[130:131], v[130:131], s[50:51] op_sel_hi:[1,0]
    v_exp_f32 v130, v130
    v_exp_f32 v131, v131
    s_nop 0
    v_add_f32 v133, v130, v131
    v_cvt_pk_bf16_f32 v130, v130, v130
    v_cvt_pk_bf16_f32 v131, v131, v131
    v_add_f32_dpp v133, v133, v133 row_ror:4 row_mask:0xf bank_mask:0xf
    v_and_b32_dpp v8, v130, v112 row_newbcast:0 row_mask:0xf bank_mask:0xf
    v_and_b32_dpp v9, v130, v113 row_newbcast:0 row_mask:0xf bank_mask:0xf
    v_and_b32_dpp v10, v130, v114 row_newbcast:0 row_mask:0xf bank_mask:0xf
    v_and_b32_dpp v11, v130, v115 row_newbcast:0 row_mask:0xf bank_mask:0xf
    v_add_f32_dpp v133, v133, v133 row_ror:8 row_mask:0xf bank_mask:0xf
    v_mov_b32 v4, v133
    v_and_b32_dpp v12, v130, v112 row_newbcast:4 row_mask:0xf bank_mask:0xf
    v_and_b32_dpp v13, v130, v113 row_newbcast:4 row_mask:0xf bank_mask:0xf
    v_and_b32_dpp v14, v130, v114 row_newbcast:4 row_mask:0xf bank_mask:0xf
    v_and_b32_dpp v15, v130, v115 row_newbcast:4 row_mask:0xf bank_mask:0xf
    v_permlane16_swap_b32 v133, v4
    v_add_f32 v133, v133, v4
    v_mov_b32 v4, v133
    v_and_b32_dpp v16, v130, v112 row_newbcast:8 row_mask:0xf bank_mask:0xf
    v_and_b32_dpp v17, v130, v113 row_newbcast:8 row_mask:0xf bank_mask:0xf
    v_and_b32_dpp v18, v130, v114 row_newbcast:8 row_mask:0xf bank_mask:0xf
    v_and_b32_dpp v19, v130, v115 row_newbcast:8 row_mask:0xf bank_mask:0xf
    v_permlane32_swap_b32 v133, v4
    v_add_f32 v133, v133, v4
    s_mov_b64 exec, 1
    ds_write_b64 v7, v[132:133] offset:352
    s_mov_b64 exec, -1
    v_and_b32_dpp v20, v130, v112 row_newbcast:12 row_mask:0xf bank_mask:0xf
    v_and_b32_dpp v21, v130, v113 row_newbcast:12 row_mask:0xf bank_mask:0xf
    v_and_b32_dpp v22, v130, v114 row_newbcast:12 row_mask:0xf bank_mask:0xf
    v_and_b32_dpp v23, v130, v115 row_newbcast:12 row_mask:0xf bank_mask:0xf
    v_and_b32_dpp v24, v131, v112 row_newbcast:0 row_mask:0xf bank_mask:0xf
    v_and_b32_dpp v25, v131, v113 row_newbcast:0 row_mask:0xf bank_mask:0xf
    v_and_b32_dpp v26, v131, v114 row_newbcast:0 row_mask:0xf bank_mask:0xf
    v_and_b32_dpp v27, v131, v115 row_newbcast:0 row_mask:0xf bank_mask:0xf
    v_and_b32_dpp v28, v131, v112 row_newbcast:4 row_mask:0xf bank_mask:0xf
    v_and_b32_dpp v29, v131, v113 row_newbcast:4 row_mask:0xf bank_mask:0xf
    v_and_b32_dpp v30, v131, v114 row_newbcast:4 row_mask:0xf bank_mask:0xf
    v_and_b32_dpp v31, v131, v115 row_newbcast:4 row_mask:0xf bank_mask:0xf
    v_and_b32_dpp v32, v131, v112 row_newbcast:8 row_mask:0xf bank_mask:0xf
    v_and_b32_dpp v33, v131, v113 row_newbcast:8 row_mask:0xf bank_mask:0xf
    v_and_b32_dpp v34, v131, v114 row_newbcast:8 row_mask:0xf bank_mask:0xf
    v_and_b32_dpp v35, v131, v115 row_newbcast:8 row_mask:0xf bank_mask:0xf
    v_and_b32_dpp v36, v131, v112 row_newbcast:12 row_mask:0xf bank_mask:0xf
    v_and_b32_dpp v37, v131, v113 row_newbcast:12 row_mask:0xf bank_mask:0xf
    v_and_b32_dpp v38, v131, v114 row_newbcast:12 row_mask:0xf bank_mask:0xf
    v_and_b32_dpp v39, v131, v115 row_newbcast:12 row_mask:0xf bank_mask:0xf
    s_setpc_b64 s[14:15]
L_mix:
    s_load_dwordx2 s[52:53], s[0:1], 64
    s_setprio 1
    s_and_b32 s30, s2, 31
    s_lshr_b32 s31, s2, 6
    s_bfe_u32 s32, s2, 0x10005
    s_lshr_b32 s33, s30, 4
    s_and_b32 s35, s2, 15
    s_lshr_b32 s36, s2, 5
    s_lshl3_add_u32 s35, s35, s36
    v_subrev_u32 v4, 64, v0
    v_lshlrev_b32 v4, 4, v4
    v_and_b32 v0, 63, v0
    s_lshl_b32 s36, s33, 10
    v_lshlrev_b32 v5, 4, v0
    v_add_u32 v5, s36, v5
    s_lshl3_add_u32 s36, s35, s36
    v_and_b32 v6, 3, v0
    v_lshlrev_b32 v6, 1, v6
    v_add_u32 v6, s36, v6
    v_mov_b32 v1, 0
    s_mov_b32 s46, 2752
    s_mov_b32 s47, 0x20000
    s_mov_b32 s50, s46
    s_mov_b32 s51, s47
    s_mov_b32 s54, s46
    s_mov_b32 s55, s47
    s_mov_b32 s58, 0xffff0000
    s_waitcnt lgkmcnt(0)
    s_mov_b64 s[44:45], s[16:17]
    s_mov_b64 s[48:49], s[18:19]
    buffer_load_dwordx4 v[28:31], v4, s[44:47], 0 offen
    buffer_load_dwordx4 v[32:35], v4, s[48:51], 0 offen
    buffer_load_dwordx4 v[36:39], v4, s[52:55], 0 offen
    s_mov_b32 s60, 0xbdd2d3e8
    s_mov_b32 s61, 0xc0135761
    s_waitcnt vmcnt(3)
    s_barrier
    ds_read_b128 v[8:11], v5 offset:6144
    ds_read_u16_d16_hi v1, v6 offset:6144
    s_waitcnt lgkmcnt(0)
    v_lshlrev_b32 v12, 16, v8
    v_and_b32 v13, s58, v8
    v_lshlrev_b32 v14, 16, v9
    v_and_b32 v15, s58, v9
    v_lshlrev_b32 v16, 16, v10
    v_and_b32 v17, s58, v10
    v_lshlrev_b32 v18, 16, v11
    v_and_b32 v19, s58, v11
    v_pk_add_f32 v[20:21], v[12:13], v[14:15]
    v_pk_add_f32 v[22:23], v[16:17], v[18:19]
    v_pk_add_f32 v[20:21], v[20:21], v[22:23]
    v_add_f32 v82, v20, v21
    s_nop 1
    v_add_f32_dpp v82, v82, v82 row_ror:8 row_mask:0xf bank_mask:0xf
    s_nop 1
    v_add_f32_dpp v82, v82, v82 row_ror:4 row_mask:0xf bank_mask:0xf
    s_nop 1
    v_add_f32_dpp v82, v82, v82 row_ror:2 row_mask:0xf bank_mask:0xf
    s_nop 1
    v_add_f32_dpp v82, v82, v82 row_ror:1 row_mask:0xf bank_mask:0xf
    v_mov_b32 v20, v82
    s_nop 1
    v_permlane16_swap_b32 v82, v20
    v_add_f32 v82, v82, v20
    v_mov_b32 v20, v82
    s_nop 1
    v_permlane32_swap_b32 v82, v20
    v_add_f32 v82, v82, v20
    v_mul_f32 v76, 0x3b000000, v82
    v_pk_add_f32 v[20:21], v[12:13], v[76:77] op_sel_hi:[1,0] neg_lo:[0,1] neg_hi:[0,1]
    v_pk_mul_f32 v[24:25], v[20:21], v[20:21]
    v_pk_add_f32 v[22:23], v[14:15], v[76:77] op_sel_hi:[1,0] neg_lo:[0,1] neg_hi:[0,1]
    v_pk_fma_f32 v[24:25], v[22:23], v[22:23], v[24:25]
    v_pk_add_f32 v[20:21], v[16:17], v[76:77] op_sel_hi:[1,0] neg_lo:[0,1] neg_hi:[0,1]
    v_pk_fma_f32 v[24:25], v[20:21], v[20:21], v[24:25]
    v_pk_add_f32 v[22:23], v[18:19], v[76:77] op_sel_hi:[1,0] neg_lo:[0,1] neg_hi:[0,1]
    v_pk_fma_f32 v[24:25], v[22:23], v[22:23], v[24:25]
    v_add_f32 v82, v24, v25
    s_nop 1
    v_add_f32_dpp v82, v82, v82 row_ror:8 row_mask:0xf bank_mask:0xf
    s_nop 1
    v_add_f32_dpp v82, v82, v82 row_ror:4 row_mask:0xf bank_mask:0xf
    s_nop 1
    v_add_f32_dpp v82, v82, v82 row_ror:2 row_mask:0xf bank_mask:0xf
    s_nop 1
    v_add_f32_dpp v82, v82, v82 row_ror:1 row_mask:0xf bank_mask:0xf
    v_mov_b32 v20, v82
    s_nop 1
    v_permlane16_swap_b32 v82, v20
    v_add_f32 v82, v82, v20
    v_mov_b32 v20, v82
    s_nop 1
    v_permlane32_swap_b32 v82, v20
    v_add_f32 v82, v82, v20
    v_mul_f32 v82, 0x3b000000, v82
    v_cvt_pk_bf16_f32 v20, v76, v82
    v_lshlrev_b32 v78, 16, v20
    v_and_b32 v82, s58, v20
    v_add_f32 v82, 0x3727c5ac, v82
    v_cvt_pk_bf16_f32 v20, v82, v82
    v_and_b32 v82, s58, v20
    v_sqrt_f32 v82, v82
    s_nop 0
    v_cvt_pk_bf16_f32 v20, v82, v82
    v_and_b32 v82, s58, v20
    v_rcp_f32 v80, v82
    s_nop 0
    v_pk_add_f32 v[20:21], v[12:13], v[78:79] op_sel_hi:[1,0] neg_lo:[0,1] neg_hi:[0,1]
    v_cvt_pk_bf16_f32 v20, v20, v21
    v_and_b32 v21, s58, v20
    v_lshlrev_b32 v20, 16, v20
    v_pk_mul_f32 v[20:21], v[20:21], v[80:81] op_sel_hi:[1,0]
    v_cvt_pk_bf16_f32 v8, v20, v21
    v_pk_add_f32 v[22:23], v[14:15], v[78:79] op_sel_hi:[1,0] neg_lo:[0,1] neg_hi:[0,1]
    v_cvt_pk_bf16_f32 v22, v22, v23
    v_and_b32 v23, s58, v22
    v_lshlrev_b32 v22, 16, v22
    v_pk_mul_f32 v[22:23], v[22:23], v[80:81] op_sel_hi:[1,0]
    v_cvt_pk_bf16_f32 v9, v22, v23
    v_pk_add_f32 v[24:25], v[16:17], v[78:79] op_sel_hi:[1,0] neg_lo:[0,1] neg_hi:[0,1]
    v_cvt_pk_bf16_f32 v24, v24, v25
    v_and_b32 v25, s58, v24
    v_lshlrev_b32 v24, 16, v24
    v_pk_mul_f32 v[24:25], v[24:25], v[80:81] op_sel_hi:[1,0]
    v_cvt_pk_bf16_f32 v10, v24, v25
    v_pk_add_f32 v[26:27], v[18:19], v[78:79] op_sel_hi:[1,0] neg_lo:[0,1] neg_hi:[0,1]
    v_cvt_pk_bf16_f32 v26, v26, v27
    v_and_b32 v27, s58, v26
    v_lshlrev_b32 v26, 16, v26
    v_pk_mul_f32 v[26:27], v[26:27], v[80:81] op_sel_hi:[1,0]
    v_cvt_pk_bf16_f32 v11, v26, v27
    v_sub_f32 v1, v1, v78
    v_cvt_pk_bf16_f32 v1, v1, v1
    v_and_b32 v1, s58, v1
    v_mul_f32 v1, v1, v80
    v_cvt_pk_bf16_f32 v1, v1, v1
    v_and_b32 v1, s58, v1
    v_lshlrev_b32 v12, 16, v8
    v_and_b32 v13, s58, v8
    v_lshlrev_b32 v14, 16, v9
    v_and_b32 v15, s58, v9
    v_lshlrev_b32 v16, 16, v10
    v_and_b32 v17, s58, v10
    v_lshlrev_b32 v18, 16, v11
    v_and_b32 v19, s58, v11
    v_pk_add_f32 v[20:21], v[12:13], v[14:15]
    v_pk_add_f32 v[22:23], v[16:17], v[18:19]
    v_pk_add_f32 v[20:21], v[20:21], v[22:23]
    v_add_f32 v82, v20, v21
    s_nop 1
    v_add_f32_dpp v82, v82, v82 row_ror:8 row_mask:0xf bank_mask:0xf
    s_nop 1
    v_add_f32_dpp v82, v82, v82 row_ror:4 row_mask:0xf bank_mask:0xf
    s_nop 1
    v_add_f32_dpp v82, v82, v82 row_ror:2 row_mask:0xf bank_mask:0xf
    s_nop 1
    v_add_f32_dpp v82, v82, v82 row_ror:1 row_mask:0xf bank_mask:0xf
    v_mov_b32 v20, v82
    s_nop 1
    v_permlane16_swap_b32 v82, v20
    v_add_f32 v82, v82, v20
    v_mov_b32 v20, v82
    s_nop 1
    v_permlane32_swap_b32 v82, v20
    v_add_f32 v82, v82, v20
    v_mul_f32 v76, 0x3b000000, v82
    v_pk_add_f32 v[20:21], v[12:13], v[76:77] op_sel_hi:[1,0] neg_lo:[0,1] neg_hi:[0,1]
    v_pk_mul_f32 v[24:25], v[20:21], v[20:21]
    v_pk_add_f32 v[22:23], v[14:15], v[76:77] op_sel_hi:[1,0] neg_lo:[0,1] neg_hi:[0,1]
    v_pk_fma_f32 v[24:25], v[22:23], v[22:23], v[24:25]
    v_pk_add_f32 v[20:21], v[16:17], v[76:77] op_sel_hi:[1,0] neg_lo:[0,1] neg_hi:[0,1]
    v_pk_fma_f32 v[24:25], v[20:21], v[20:21], v[24:25]
    v_pk_add_f32 v[22:23], v[18:19], v[76:77] op_sel_hi:[1,0] neg_lo:[0,1] neg_hi:[0,1]
    v_pk_fma_f32 v[24:25], v[22:23], v[22:23], v[24:25]
    v_add_f32 v82, v24, v25
    s_nop 1
    v_add_f32_dpp v82, v82, v82 row_ror:8 row_mask:0xf bank_mask:0xf
    s_nop 1
    v_add_f32_dpp v82, v82, v82 row_ror:4 row_mask:0xf bank_mask:0xf
    s_nop 1
    v_add_f32_dpp v82, v82, v82 row_ror:2 row_mask:0xf bank_mask:0xf
    s_nop 1
    v_add_f32_dpp v82, v82, v82 row_ror:1 row_mask:0xf bank_mask:0xf
    v_mov_b32 v20, v82
    s_nop 1
    v_permlane16_swap_b32 v82, v20
    v_add_f32 v82, v82, v20
    v_mov_b32 v20, v82
    s_nop 1
    v_permlane32_swap_b32 v82, v20
    v_add_f32 v82, v82, v20
    v_mul_f32 v82, 0x3b000000, v82
    v_cvt_pk_bf16_f32 v20, v76, v82
    v_lshlrev_b32 v78, 16, v20
    v_and_b32 v82, s58, v20
    v_add_f32 v82, 0x3727c5ac, v82
    v_cvt_pk_bf16_f32 v20, v82, v82
    v_and_b32 v82, s58, v20
    v_sqrt_f32 v82, v82
    s_nop 0
    v_cvt_pk_bf16_f32 v20, v82, v82
    v_and_b32 v82, s58, v20
    v_rcp_f32 v80, v82
    s_nop 0
    v_sub_f32 v1, v1, v78
    v_cvt_pk_bf16_f32 v1, v1, v1
    v_and_b32 v1, s58, v1
    v_mul_f32 v1, v1, v80
    v_cvt_pk_bf16_f32 v1, v1, v1
    v_and_b32 v1, s58, v1
    s_waitcnt vmcnt(0)
    v_readlane_b32 s62, v1, 0
    v_readlane_b32 s63, v1, 1
    v_readlane_b32 s64, v1, 2
    v_readlane_b32 s65, v1, 3
    v_lshlrev_b32 v40, 16, v28
    v_and_b32 v41, s58, v28
    v_lshlrev_b32 v48, 16, v32
    v_and_b32 v49, s58, v32
    v_lshlrev_b32 v42, 16, v29
    v_and_b32 v43, s58, v29
    v_lshlrev_b32 v50, 16, v33
    v_and_b32 v51, s58, v33
    v_lshlrev_b32 v44, 16, v30
    v_and_b32 v45, s58, v30
    v_lshlrev_b32 v52, 16, v34
    v_and_b32 v53, s58, v34
    v_lshlrev_b32 v46, 16, v31
    v_and_b32 v47, s58, v31
    v_lshlrev_b32 v54, 16, v35
    v_and_b32 v55, s58, v35
    v_mov_b32 v72, 0
    v_mov_b32 v73, 0
    v_mov_b32 v74, 0
    v_mov_b32 v75, 0
    s_mov_b32 s36, 0
L_mloop:
    v_pk_mul_f32 v[56:57], v[40:41], s[62:63] op_sel_hi:[1,0]
    v_pk_mul_f32 v[60:61], v[40:41], s[62:63] op_sel:[0,1] op_sel_hi:[1,1]
    v_cvt_pk_bf16_f32 v56, v56, v57
    v_cvt_pk_bf16_f32 v60, v60, v61
    v_and_b32 v57, s58, v56
    v_and_b32 v61, s58, v60
    v_lshlrev_b32 v56, 16, v56
    v_lshlrev_b32 v60, 16, v60
    v_pk_add_f32 v[56:57], v[56:57], v[48:49]
    v_pk_add_f32 v[60:61], v[60:61], v[48:49]
    v_cvt_pk_bf16_f32 v56, v56, v57
    v_cvt_pk_bf16_f32 v60, v60, v61
    v_and_b32 v57, s58, v56
    v_and_b32 v61, s58, v60
    v_lshlrev_b32 v56, 16, v56
    v_lshlrev_b32 v60, 16, v60
    v_pk_mul_f32 v[58:59], v[56:57], v[56:57]
    v_pk_mul_f32 v[62:63], v[60:61], v[60:61]
    v_pk_fma_f32 v[58:59], v[58:59], s[60:61], s[60:61] op_sel:[0,0,1] op_sel_hi:[1,0,1]
    v_pk_fma_f32 v[62:63], v[62:63], s[60:61], s[60:61] op_sel:[0,0,1] op_sel_hi:[1,0,1]
    v_pk_mul_f32 v[58:59], v[58:59], v[56:57]
    v_pk_mul_f32 v[62:63], v[62:63], v[60:61]
    v_exp_f32 v58, v58
    v_exp_f32 v62, v62
    v_exp_f32 v59, v59
    v_exp_f32 v63, v63
    v_pk_add_f32 v[58:59], v[58:59], 1.0 op_sel_hi:[1,0]
    v_pk_add_f32 v[62:63], v[62:63], 1.0 op_sel_hi:[1,0]
    v_rcp_f32 v58, v58
    v_rcp_f32 v62, v62
    v_rcp_f32 v59, v59
    v_rcp_f32 v63, v63
    v_pk_mul_f32 v[56:57], v[56:57], v[58:59]
    v_pk_mul_f32 v[60:61], v[60:61], v[62:63]
    v_cvt_pk_bf16_f32 v56, v56, v57
    v_cvt_pk_bf16_f32 v60, v60, v61
    v_dot2c_f32_bf16 v72, v56, v36
    v_dot2c_f32_bf16 v73, v60, v36
    v_pk_mul_f32 v[56:57], v[42:43], s[62:63] op_sel_hi:[1,0]
    v_pk_mul_f32 v[60:61], v[42:43], s[62:63] op_sel:[0,1] op_sel_hi:[1,1]
    v_cvt_pk_bf16_f32 v56, v56, v57
    v_cvt_pk_bf16_f32 v60, v60, v61
    v_and_b32 v57, s58, v56
    v_and_b32 v61, s58, v60
    v_lshlrev_b32 v56, 16, v56
    v_lshlrev_b32 v60, 16, v60
    v_pk_add_f32 v[56:57], v[56:57], v[50:51]
    v_pk_add_f32 v[60:61], v[60:61], v[50:51]
    v_cvt_pk_bf16_f32 v56, v56, v57
    v_cvt_pk_bf16_f32 v60, v60, v61
    v_and_b32 v57, s58, v56
    v_and_b32 v61, s58, v60
    v_lshlrev_b32 v56, 16, v56
    v_lshlrev_b32 v60, 16, v60
    v_pk_mul_f32 v[58:59], v[56:57], v[56:57]
    v_pk_mul_f32 v[62:63], v[60:61], v[60:61]
    v_pk_fma_f32 v[58:59], v[58:59], s[60:61], s[60:61] op_sel:[0,0,1] op_sel_hi:[1,0,1]
    v_pk_fma_f32 v[62:63], v[62:63], s[60:61], s[60:61] op_sel:[0,0,1] op_sel_hi:[1,0,1]
    v_pk_mul_f32 v[58:59], v[58:59], v[56:57]
    v_pk_mul_f32 v[62:63], v[62:63], v[60:61]
    v_exp_f32 v58, v58
    v_exp_f32 v62, v62
    v_exp_f32 v59, v59
    v_exp_f32 v63, v63
    v_pk_add_f32 v[58:59], v[58:59], 1.0 op_sel_hi:[1,0]
    v_pk_add_f32 v[62:63], v[62:63], 1.0 op_sel_hi:[1,0]
    v_rcp_f32 v58, v58
    v_rcp_f32 v62, v62
    v_rcp_f32 v59, v59
    v_rcp_f32 v63, v63
    v_pk_mul_f32 v[56:57], v[56:57], v[58:59]
    v_pk_mul_f32 v[60:61], v[60:61], v[62:63]
    v_cvt_pk_bf16_f32 v56, v56, v57
    v_cvt_pk_bf16_f32 v60, v60, v61
    v_dot2c_f32_bf16 v72, v56, v37
    v_dot2c_f32_bf16 v73, v60, v37
    v_pk_mul_f32 v[56:57], v[44:45], s[62:63] op_sel_hi:[1,0]
    v_pk_mul_f32 v[60:61], v[44:45], s[62:63] op_sel:[0,1] op_sel_hi:[1,1]
    v_cvt_pk_bf16_f32 v56, v56, v57
    v_cvt_pk_bf16_f32 v60, v60, v61
    v_and_b32 v57, s58, v56
    v_and_b32 v61, s58, v60
    v_lshlrev_b32 v56, 16, v56
    v_lshlrev_b32 v60, 16, v60
    v_pk_add_f32 v[56:57], v[56:57], v[52:53]
    v_pk_add_f32 v[60:61], v[60:61], v[52:53]
    v_cvt_pk_bf16_f32 v56, v56, v57
    v_cvt_pk_bf16_f32 v60, v60, v61
    v_and_b32 v57, s58, v56
    v_and_b32 v61, s58, v60
    v_lshlrev_b32 v56, 16, v56
    v_lshlrev_b32 v60, 16, v60
    v_pk_mul_f32 v[58:59], v[56:57], v[56:57]
    v_pk_mul_f32 v[62:63], v[60:61], v[60:61]
    v_pk_fma_f32 v[58:59], v[58:59], s[60:61], s[60:61] op_sel:[0,0,1] op_sel_hi:[1,0,1]
    v_pk_fma_f32 v[62:63], v[62:63], s[60:61], s[60:61] op_sel:[0,0,1] op_sel_hi:[1,0,1]
    v_pk_mul_f32 v[58:59], v[58:59], v[56:57]
    v_pk_mul_f32 v[62:63], v[62:63], v[60:61]
    v_exp_f32 v58, v58
    v_exp_f32 v62, v62
    v_exp_f32 v59, v59
    v_exp_f32 v63, v63
    v_pk_add_f32 v[58:59], v[58:59], 1.0 op_sel_hi:[1,0]
    v_pk_add_f32 v[62:63], v[62:63], 1.0 op_sel_hi:[1,0]
    v_rcp_f32 v58, v58
    v_rcp_f32 v62, v62
    v_rcp_f32 v59, v59
    v_rcp_f32 v63, v63
    v_pk_mul_f32 v[56:57], v[56:57], v[58:59]
    v_pk_mul_f32 v[60:61], v[60:61], v[62:63]
    v_cvt_pk_bf16_f32 v56, v56, v57
    v_cvt_pk_bf16_f32 v60, v60, v61
    v_dot2c_f32_bf16 v72, v56, v38
    v_dot2c_f32_bf16 v73, v60, v38
    v_pk_mul_f32 v[56:57], v[46:47], s[62:63] op_sel_hi:[1,0]
    v_pk_mul_f32 v[60:61], v[46:47], s[62:63] op_sel:[0,1] op_sel_hi:[1,1]
    v_cvt_pk_bf16_f32 v56, v56, v57
    v_cvt_pk_bf16_f32 v60, v60, v61
    v_and_b32 v57, s58, v56
    v_and_b32 v61, s58, v60
    v_lshlrev_b32 v56, 16, v56
    v_lshlrev_b32 v60, 16, v60
    v_pk_add_f32 v[56:57], v[56:57], v[54:55]
    v_pk_add_f32 v[60:61], v[60:61], v[54:55]
    v_cvt_pk_bf16_f32 v56, v56, v57
    v_cvt_pk_bf16_f32 v60, v60, v61
    v_and_b32 v57, s58, v56
    v_and_b32 v61, s58, v60
    v_lshlrev_b32 v56, 16, v56
    v_lshlrev_b32 v60, 16, v60
    v_pk_mul_f32 v[58:59], v[56:57], v[56:57]
    v_pk_mul_f32 v[62:63], v[60:61], v[60:61]
    v_pk_fma_f32 v[58:59], v[58:59], s[60:61], s[60:61] op_sel:[0,0,1] op_sel_hi:[1,0,1]
    v_pk_fma_f32 v[62:63], v[62:63], s[60:61], s[60:61] op_sel:[0,0,1] op_sel_hi:[1,0,1]
    v_pk_mul_f32 v[58:59], v[58:59], v[56:57]
    v_pk_mul_f32 v[62:63], v[62:63], v[60:61]
    v_exp_f32 v58, v58
    v_exp_f32 v62, v62
    v_exp_f32 v59, v59
    v_exp_f32 v63, v63
    v_pk_add_f32 v[58:59], v[58:59], 1.0 op_sel_hi:[1,0]
    v_pk_add_f32 v[62:63], v[62:63], 1.0 op_sel_hi:[1,0]
    v_rcp_f32 v58, v58
    v_rcp_f32 v62, v62
    v_rcp_f32 v59, v59
    v_rcp_f32 v63, v63
    v_pk_mul_f32 v[56:57], v[56:57], v[58:59]
    v_pk_mul_f32 v[60:61], v[60:61], v[62:63]
    v_cvt_pk_bf16_f32 v56, v56, v57
    v_cvt_pk_bf16_f32 v60, v60, v61
    v_dot2c_f32_bf16 v72, v56, v39
    v_dot2c_f32_bf16 v73, v60, v39
    s_cmp_lg_u32 s36, 0
    s_cbranch_scc1 L_mdone
    s_mov_b32 s36, 1
    s_mov_b64 s[62:63], s[64:65]
    v_mov_b32 v74, v72
    v_mov_b32 v75, v73
    v_mov_b32 v72, 0
    v_mov_b32 v73, 0
    s_branch L_mloop
L_mdone:
    s_lshr_b32 s36, s3, 2
    s_sub_u32 s36, s36, 16
    v_lshrrev_b32 v20, 2, v0
    v_add_u32 v20, s36, v20
    v_permlane32_swap_b32 v74, v72
    v_permlane32_swap_b32 v75, v73
    v_pk_add_f32 v[72:73], v[72:73], v[74:75]
    s_nop 1
    v_permlane16_swap_b32 v72, v73
    v_add_f32 v72, v72, v73
    s_nop 1
    v_add_f32_dpp v72, v72, v72 row_ror:8 row_mask:0xf bank_mask:0xf
    s_nop 1
    v_add_f32_dpp v72, v72, v72 row_ror:4 row_mask:0xf bank_mask:0xf
    s_nop 1
    v_add_f32_dpp v72, v72, v72 row_ror:2 row_mask:0xf bank_mask:0xf
    s_nop 1
    v_add_f32_dpp v72, v72, v72 row_ror:1 row_mask:0xf bank_mask:0xf
    s_mov_b32 s68, 0x00010001
    s_mov_b32 s69, s68
    s_mov_b64 exec, s[68:69]
    ds_write_b32 v20, v72 offset:320
    s_waitcnt lgkmcnt(0)
L_mend:
    s_endpgm
    .fill 46, 4, 0xbf810000
.section .rodata,"a"
.p2align 6
.amdhsa_kernel recurrent_scan__sliding_block_cached__mixer_token_mlp__decode_kernel
  .amdhsa_next_free_vgpr 168
  .amdhsa_next_free_sgpr 96
  .amdhsa_accum_offset 168
  .amdhsa_group_segment_fixed_size 0
  .amdhsa_kernarg_size 104
  .amdhsa_user_sgpr_count 2
  .amdhsa_user_sgpr_kernarg_segment_ptr 1
  .amdhsa_system_sgpr_workgroup_id_x 1
  .amdhsa_float_denorm_mode_32 3
.end_amdhsa_kernel
```
